```python
import torch

def _softmax(x, axis=-1):
    return torch.softmax(x, dim=axis)

def _gelu(x):
    return torch.nn.functional.gelu(x, approximate='tanh')

def _silu(x):
    return torch.nn.functional.silu(x)

def _sigmoid(x):
    return torch.sigmoid(x)

def _layernorm(x, axis=-1, eps=1e-05):
    m = x.mean(dim=axis, keepdim=True)
    v = x.var(dim=axis, keepdim=True, unbiased=False)
    return (x - m) / torch.sqrt(v + eps)

def _scatter_add(tgt, idx, src, axis=0):
    return tgt.clone().index_add_(axis, idx, src)

def _segment_sum(src, seg, n):
    out = torch.zeros((n,) + src.shape[1:], dtype=src.dtype)
    return out.index_add_(0, seg, src)

def _pad(x, pw):
    flat = tuple((v for pair in reversed(pw) for v in pair))
    return torch.nn.functional.pad(x, flat)
kernel_name = 'standalone__autoregressive_conv_wavernn__speech'

def setup_inputs():

    _w = lambda a: (lambda t: t.to(torch.bfloat16) if t.is_floating_point() else t)(torch.as_tensor(a))
    B, T, D, K = (2, 4000, 256, 3)
    return {'x': _w((lambda *s: torch.randn(*s, dtype=torch.bfloat16) * 0.1)(B, T, D)), 'w': _w((lambda *s: torch.randn(*s, dtype=torch.bfloat16) * 0.1)(K, D, 2 * D))}

def reference(x, w):
    B, T, D = x.shape
    K = w.shape[0]
    dil = 2
    pad = (K - 1) * dil
    xp = _pad(x, ((0, 0), (pad, 0), (0, 0)))
    h = torch.einsum('btd,de->bte', xp[:, 0:T, :], w[0])
    for i in range(1, K):
        h = h + torch.einsum('btd,de->bte', xp[:, i * dil:i * dil + T, :], w[i])
    f, g = (h[..., :D].clone(), h[..., D:].clone())
    return torch.tanh(f) * _sigmoid(g)
```

```asm
; @launch grid=(256,1,1) block=(512,1,1) lds=159744
.amdgcn_target "amdgcn-amd-amdhsa--gfx950"
.text
.globl standalone__autoregressive_conv_wavernn__speech_kernel
.p2align 12
.p2align 8
.type standalone__autoregressive_conv_wavernn__speech_kernel,@function
standalone__autoregressive_conv_wavernn__speech_kernel:
    s_load_dwordx2 s[12:13], s[0:1], 8
    s_load_dwordx2 s[8:9], s[0:1], 0
    s_load_dwordx2 s[24:25], s[0:1], 16
    s_cmpk_ge_u32 s2, 256
    v_readfirstlane_b32 s3, v0
    s_cbranch_scc1 L_end
    s_cmpk_ge_u32 s3, 384
    s_cbranch_scc1 L_pad0
    s_cmpk_ge_u32 s3, 256
    s_cbranch_scc1 L_cpro
    v_lshrrev_b32 v6, 3, v0
    s_and_b32 s18, s2, 0x18
    v_xor_b32 v6, v6, v0
    s_lshl_b32 s18, s18, 4
    v_bfi_b32 v9, 6, v6, v0
    s_and_b32 s4, s3, 0x80
    v_and_b32 v9, 7, v9
    s_lshl2_add_u32 s22, s4, s18
    v_and_b32 v5, 0xf8, v0
    s_lshl_b32 s21, s3, 4
    v_lshlrev_b32 v5, 6, v5
    s_mov_b32 s14, 786432
    v_lshl_add_u32 v5, v9, 4, v5
    s_mov_b32 s15, 0x20000
    v_xor_b32 v5, s22, v5
    s_mov_b32 m0, s21
    s_lshr_b32 s17, s2, 5
    s_and_b32 s16, s2, 3
    s_lshl3_add_u32 s19, s16, s17
    s_mulk_i32 s19, 125
    s_lshr_b32 s31, s3, 6
    s_add_u32 s20, s19, s31
    s_sub_u32 s20, s20, 4
    s_lshl_b32 s20, s20, 9
    v_bfi_b32 v9, 2, v6, v0
    v_and_b32 v9, 7, v9
    v_lshl_add_u32 v3, v9, 4, s20
    v_and_b32 v9, 56, v0
    v_lshl_add_u32 v3, v9, 10, v3
    v_add_u32 v7, 0x800, v3
    s_bfe_u32 s16, s2, 0x10002
    s_mul_i32 s16, s16, 2048000
    s_mul_i32 s23, s3, 17
    s_lshr_b32 s4, s4, 1
    s_sub_u32 s23, s4, s23
    s_mov_b32 s10, 2048000
    s_mov_b32 s11, 0x20000
    s_waitcnt lgkmcnt(0)
    buffer_load_dwordx4 v5, s[12:15], 0 offen lds
    s_add_u32 s8, s8, s16
    s_addc_u32 s9, s9, 0
    s_add_u32 m0, s21, 4096
    s_mov_b32 s22, 16384
    buffer_load_dwordx4 v5, s[12:15], s22 offen lds
    s_add_u32 m0, s23, 105984
    s_movk_i32 s22, 0
    buffer_load_dwordx4 v3, s[8:11], s22 offen lds
    s_add_u32 s22, s19, 124
    s_lshl2_add_u32 s22, s22, s31
    s_lshl_b32 s22, s22, 7
    v_and_b32 v4, 7, v0
    v_lshl_add_u32 v8, v4, 4, s22
    s_mul_i32 s5, s31, 17024
    s_cmp_eq_u32 s31, 3
    s_cselect_b32 s5, 0, s5
    s_cmp_eq_u32 s31, 0
    s_cselect_b32 s5, -128, s5
    s_add_u32 m0, s23, 101760
    s_movk_i32 s22, 0
    buffer_load_dwordx4 v7, s[8:11], s22 offen lds
    s_lshl2_add_u32 s22, s2, s31
    s_lshl_b32 s22, s22, 7
    v_and_b32 v12, 3, v0
    v_lshl_add_u32 v10, v12, 18, s22
    v_and_b32 v13, 4, v0
    v_lshl_add_u32 v10, v13, 15, v10
    s_add_u32 m0, s23, 97536
    s_movk_i32 s22, 2048
    buffer_load_dwordx4 v7, s[8:11], s22 offen lds
    s_add_u32 m0, s23, 93312
    s_movk_i32 s22, 4096
    buffer_load_dwordx4 v7, s[8:11], s22 offen lds
    s_add_u32 m0, s5, 107136
    s_mov_b64 exec, 0xff
    buffer_load_dwordx4 v8, s[8:11], 0 offen lds
    s_mov_b32 m0, 141312
    s_mov_b64 exec, 0x77
    buffer_load_dword v10, s[12:15], 0 offen lds
    s_mov_b64 exec, -1
    s_add_u32 m0, s21, 8192
    s_mov_b32 s22, 262144
    buffer_load_dwordx4 v5, s[12:15], s22 offen lds
    s_lshr_b32 s22, s2, 3
    s_lshl2_add_u32 s22, s22, s31
    s_lshl_b32 s22, s22, 9
    s_addk_i32 s22, 384
    v_and_b32 v12, 3, v0
    v_lshl_add_u32 v19, v12, 18, s22
    v_and_b32 v13, 12, v0
    v_lshl_add_u32 v19, v13, 14, v19
    s_add_u32 m0, s21, 12288
    s_mov_b32 s22, 278528
    buffer_load_dwordx4 v5, s[12:15], s22 offen lds
    v_lshrrev_b32 v14, 3, v0
    v_lshlrev_b32 v15, 4, v4
    v_mul_u32_u24 v16, 144, v14
    s_mov_b32 s6, 141312
    v_add3_u32 v16, v16, v15, s6
    v_bfe_u32 v17, v0, 4, 3
    v_and_b32 v14, 1, v14
    v_lshl_add_u32 v17, v17, 4, v14
    v_lshrrev_b32 v14, 7, v0
    v_lshl_add_u32 v17, v14, 1, v17
    v_lshl_add_u32 v17, v17, 9, v15
    v_add_u32 v17, s18, v17
    v_add_u32 v18, 0x1000, v17
    s_lshl_b32 s22, s19, 9
    s_add_u32 s16, s16, s22
    s_mov_b32 s26, 64000
    s_mov_b32 s27, 0x20000
    s_add_u32 s24, s24, s16
    s_addc_u32 s25, s25, 0
    s_add_u32 m0, s21, 16384
    s_mov_b32 s22, 524288
    buffer_load_dwordx4 v5, s[12:15], s22 offen lds
    s_add_u32 m0, s21, 20480
    s_mov_b32 s22, 540672
    buffer_load_dwordx4 v5, s[12:15], s22 offen lds
    s_add_u32 m0, s21, 24576
    s_mov_b32 s22, 32768
    buffer_load_dwordx4 v5, s[12:15], s22 offen lds
    s_waitcnt vmcnt(10)
    s_barrier
    s_add_u32 m0, s21, 28672
    s_mov_b32 s22, 49152
    buffer_load_dwordx4 v5, s[12:15], s22 offen lds
    s_add_u32 m0, s21, 32768
    s_mov_b32 s22, 294912
    buffer_load_dwordx4 v5, s[12:15], s22 offen lds
    s_waitcnt vmcnt(11)
    s_barrier
    s_add_u32 m0, s21, 36864
    s_mov_b32 s22, 311296
    buffer_load_dwordx4 v5, s[12:15], s22 offen lds
    s_waitcnt vmcnt(11)
    s_barrier
    s_add_u32 m0, s21, 40960
    s_mov_b32 s22, 557056
    buffer_load_dwordx4 v5, s[12:15], s22 offen lds
    s_waitcnt vmcnt(11)
    s_barrier
    s_add_u32 m0, s21, 45056
    s_mov_b32 s22, 573440
    buffer_load_dwordx4 v5, s[12:15], s22 offen lds
    s_add_u32 m0, s23, 123136
    s_movk_i32 s22, 128
    buffer_load_dwordx4 v3, s[8:11], s22 offen lds
    s_add_u32 m0, s23, 118912
    s_movk_i32 s22, 128
    buffer_load_dwordx4 v7, s[8:11], s22 offen lds
    s_add_u32 m0, s23, 114688
    s_movk_i32 s22, 2176
    buffer_load_dwordx4 v7, s[8:11], s22 offen lds
    s_waitcnt vmcnt(11)
    s_barrier
    s_add_u32 m0, s23, 110464
    s_movk_i32 s22, 4224
    buffer_load_dwordx4 v7, s[8:11], s22 offen lds
    s_add_u32 m0, s23, 140160
    s_movk_i32 s22, 256
    buffer_load_dwordx4 v3, s[8:11], s22 offen lds
    s_waitcnt vmcnt(11)
    s_barrier
    s_add_u32 m0, s23, 135936
    s_movk_i32 s22, 256
    buffer_load_dwordx4 v7, s[8:11], s22 offen lds
    s_add_u32 m0, s23, 131712
    s_movk_i32 s22, 2304
    buffer_load_dwordx4 v7, s[8:11], s22 offen lds
    s_waitcnt vmcnt(11)
    s_barrier
    s_add_u32 m0, s23, 127488
    s_movk_i32 s22, 4352
    buffer_load_dwordx4 v7, s[8:11], s22 offen lds
    s_add_u32 m0, s21, 49152
    s_mov_b32 s22, 65536
    buffer_load_dwordx4 v5, s[12:15], s22 offen lds
    s_waitcnt vmcnt(11)
    s_barrier
    s_add_u32 m0, s21, 53248
    s_mov_b32 s22, 81920
    buffer_load_dwordx4 v5, s[12:15], s22 offen lds
    s_add_u32 m0, s21, 57344
    s_mov_b32 s22, 327680
    buffer_load_dwordx4 v5, s[12:15], s22 offen lds
    s_waitcnt vmcnt(11)
    s_barrier
    s_add_u32 m0, s21, 61440
    s_mov_b32 s22, 344064
    buffer_load_dwordx4 v5, s[12:15], s22 offen lds
    s_add_u32 m0, s21, 65536
    s_mov_b32 s22, 589824
    buffer_load_dwordx4 v5, s[12:15], s22 offen lds
    s_add_u32 m0, s21, 69632
    s_mov_b32 s22, 606208
    buffer_load_dwordx4 v5, s[12:15], s22 offen lds
    s_add_u32 m0, s21, 73728
    s_mov_b32 s22, 98304
    buffer_load_dwordx4 v5, s[12:15], s22 offen lds
    s_add_u32 m0, s21, 77824
    s_mov_b32 s22, 114688
    buffer_load_dwordx4 v5, s[12:15], s22 offen lds
    s_add_u32 m0, s21, 81920
    s_mov_b32 s22, 360448
    buffer_load_dwordx4 v5, s[12:15], s22 offen lds
    s_add_u32 m0, s21, 86016
    s_mov_b32 s22, 376832
    buffer_load_dwordx4 v5, s[12:15], s22 offen lds
    s_add_u32 m0, s21, 0
    s_mov_b32 s22, 622592
    buffer_load_dwordx4 v5, s[12:15], s22 offen lds
    s_add_u32 m0, s21, 4096
    s_mov_b32 s22, 638976
    buffer_load_dwordx4 v5, s[12:15], s22 offen lds
    s_waitcnt vmcnt(10)
    s_barrier
    s_waitcnt vmcnt(8)
    s_barrier
    s_mov_b32 m0, 141312
    s_mov_b64 exec, 0x7000
    buffer_load_dword v19, s[12:15], 0 offen lds
    s_mov_b64 exec, -1
    s_waitcnt vmcnt(7)
    s_barrier
    s_add_u32 m0, s21, 8192
    s_mov_b32 s22, 131072
    buffer_load_dwordx4 v5, s[12:15], s22 offen lds
    s_add_u32 m0, s21, 12288
    s_mov_b32 s22, 147456
    buffer_load_dwordx4 v5, s[12:15], s22 offen lds
    s_add_u32 m0, s21, 16384
    s_mov_b32 s22, 393216
    buffer_load_dwordx4 v5, s[12:15], s22 offen lds
    s_add_u32 m0, s21, 20480
    s_mov_b32 s22, 409600
    buffer_load_dwordx4 v5, s[12:15], s22 offen lds
    s_add_u32 m0, s21, 24576
    s_mov_b32 s22, 655360
    buffer_load_dwordx4 v5, s[12:15], s22 offen lds
    s_add_u32 m0, s21, 28672
    s_mov_b32 s22, 671744
    buffer_load_dwordx4 v5, s[12:15], s22 offen lds
    s_add_u32 m0, s21, 32768
    s_mov_b32 s22, 163840
    buffer_load_dwordx4 v5, s[12:15], s22 offen lds
    s_waitcnt vmcnt(8)
    s_barrier
    s_add_u32 m0, s21, 36864
    s_mov_b32 s22, 180224
    buffer_load_dwordx4 v5, s[12:15], s22 offen lds
    s_add_u32 m0, s21, 40960
    s_mov_b32 s22, 425984
    buffer_load_dwordx4 v5, s[12:15], s22 offen lds
    s_add_u32 m0, s21, 45056
    s_mov_b32 s22, 442368
    buffer_load_dwordx4 v5, s[12:15], s22 offen lds
    s_add_u32 m0, s21, 49152
    s_mov_b32 s22, 688128
    buffer_load_dwordx4 v5, s[12:15], s22 offen lds
    s_add_u32 m0, s21, 53248
    s_mov_b32 s22, 704512
    buffer_load_dwordx4 v5, s[12:15], s22 offen lds
    s_add_u32 m0, s23, 106112
    s_movk_i32 s22, 384
    buffer_load_dwordx4 v3, s[8:11], s22 offen lds
    s_add_u32 m0, s23, 101888
    s_movk_i32 s22, 384
    buffer_load_dwordx4 v7, s[8:11], s22 offen lds
    s_add_u32 m0, s23, 97664
    s_movk_i32 s22, 2432
    buffer_load_dwordx4 v7, s[8:11], s22 offen lds
    s_add_u32 m0, s23, 93440
    s_movk_i32 s22, 4480
    buffer_load_dwordx4 v7, s[8:11], s22 offen lds
    s_add_u32 m0, s21, 57344
    s_mov_b32 s22, 196608
    buffer_load_dwordx4 v5, s[12:15], s22 offen lds
    s_waitcnt vmcnt(11)
    s_barrier
    s_add_u32 m0, s21, 61440
    s_mov_b32 s22, 212992
    buffer_load_dwordx4 v5, s[12:15], s22 offen lds
    s_add_u32 m0, s21, 65536
    s_mov_b32 s22, 458752
    buffer_load_dwordx4 v5, s[12:15], s22 offen lds
    s_add_u32 m0, s21, 69632
    s_mov_b32 s22, 475136
    buffer_load_dwordx4 v5, s[12:15], s22 offen lds
    s_add_u32 m0, s21, 73728
    s_mov_b32 s22, 720896
    buffer_load_dwordx4 v5, s[12:15], s22 offen lds
    s_add_u32 m0, s21, 77824
    s_mov_b32 s22, 737280
    buffer_load_dwordx4 v5, s[12:15], s22 offen lds
    s_add_u32 m0, s21, 81920
    s_mov_b32 s22, 229376
    buffer_load_dwordx4 v5, s[12:15], s22 offen lds
    s_add_u32 m0, s21, 86016
    s_mov_b32 s22, 245760
    buffer_load_dwordx4 v5, s[12:15], s22 offen lds
    s_waitcnt vmcnt(12)
    s_barrier
    s_add_u32 m0, s21, 0
    s_mov_b32 s22, 491520
    buffer_load_dwordx4 v5, s[12:15], s22 offen lds
    s_add_u32 m0, s21, 4096
    s_mov_b32 s22, 507904
    buffer_load_dwordx4 v5, s[12:15], s22 offen lds
    s_add_u32 m0, s21, 8192
    s_mov_b32 s22, 753664
    buffer_load_dwordx4 v5, s[12:15], s22 offen lds
    s_waitcnt vmcnt(11)
    s_barrier
    s_add_u32 m0, s21, 12288
    s_mov_b32 s22, 770048
    buffer_load_dwordx4 v5, s[12:15], s22 offen lds
    s_waitcnt vmcnt(10)
    s_barrier
    s_waitcnt vmcnt(8)
    s_barrier
    s_waitcnt vmcnt(6)
    s_barrier
    s_waitcnt vmcnt(4)
    s_barrier
    s_waitcnt vmcnt(2)
    s_barrier
    s_waitcnt vmcnt(0)
    s_barrier
    s_barrier
    ds_read_b128 v[32:35], v16 offset:0
    s_waitcnt lgkmcnt(0)
    buffer_store_dwordx4 v[32:35], v17, s[24:27], 0 offen offset:0 sc1
    s_barrier
    ds_read_b128 v[36:39], v16 offset:4608
    s_waitcnt lgkmcnt(0)
    buffer_store_dwordx4 v[36:39], v17, s[24:27], 0 offen offset:2048 sc1
    s_barrier
    ds_read_b128 v[40:43], v16 offset:9216
    s_waitcnt lgkmcnt(0)
    buffer_store_dwordx4 v[40:43], v18, s[24:27], 0 offen offset:0 sc1
    s_barrier
    ds_read_b128 v[44:47], v16 offset:13824
    s_waitcnt lgkmcnt(0)
    buffer_store_dwordx4 v[44:47], v18, s[24:27], 0 offen offset:2048 sc1
    s_endpgm
.p2align 12
L_cpro:
    v_bfe_u32 v14, v0, 4, 2
    v_and_b32 v15, 15, v0
    v_mul_u32_u24 v15, 144, v15
    s_lshr_b32 s21, s3, 1
    s_add_u32 s21, s21, 141184
    v_lshl_add_u32 v15, v14, 3, v15
    v_add_u32 v15, s21, v15
    s_bfe_u32 s3, s3, 0x20006
    v_and_b32 v12, 1, v0
    v_mul_u32_u24 v12, 1088, v12
    v_sub_u32 v12, 91200, v12
    v_bfe_u32 v13, v0, 1, 3
    v_and_b32 v9, 2, v13
    v_xor_b32 v9, v9, v14
    v_lshl_add_u32 v9, v13, 3, v9
    v_lshl_add_u32 v2, v9, 4, v12
    v_add_u32 v13, 1, v13
    v_and_b32 v9, 2, v13
    v_xor_b32 v9, v9, v14
    v_lshl_add_u32 v9, v13, 3, v9
    v_lshl_add_u32 v3, v9, 4, v12
    v_bfe_u32 v13, v0, 2, 2
    v_lshl_add_u32 v4, v14, 3, v13
    v_lshlrev_b32 v4, 8, v4
    v_xor_b32 v13, s3, v13
    v_lshl_add_u32 v4, v13, 5, v4
    v_bfe_u32 v13, v0, 4, 1
    v_lshl_add_u32 v4, v13, 7, v4
    v_and_b32 v13, 3, v0
    v_lshl_add_u32 v4, v13, 3, v4
    v_add_u32 v5, 49152, v4
    v_xor_b32 v6, 0x80, v4
    v_xor_b32 v7, 0x80, v5
    s_mov_b32 s28, 0xc038aa3b
    s_mov_b32 s29, 0xbfb8aa3b
    s_mov_b32 s30, 0x30800000
    s_mov_b32 s31, 0x31000000
    s_cmp_eq_u32 0, 1
    s_waitcnt lgkmcnt(0)
    s_barrier
    ds_read_b64_tr_b16 v[80:81], v6 offset:0
    ds_read_b64_tr_b16 v[82:83], v6 offset:1024
    ds_read_b128 v[84:87], v2 offset:14784
    ds_read_b64_tr_b16 v[88:89], v4 offset:0
    ds_read_b64_tr_b16 v[90:91], v4 offset:1024
    ds_read_b128 v[92:95], v2 offset:12672
    s_barrier
    ds_read_b128 v[96:99], v2 offset:10560
    ds_read_b128 v[100:103], v2 offset:8448
    s_waitcnt lgkmcnt(5)
    v_mfma_f32_16x16x32_bf16 v[20:23], v[80:83], v[84:87], 0
    s_waitcnt lgkmcnt(3)
    s_barrier
    v_mfma_f32_16x16x32_bf16 v[16:19], v[88:91], v[84:87], 0
    s_waitcnt lgkmcnt(2)
    ds_read_b128 v[104:107], v2 offset:6336
    v_mfma_f32_16x16x32_bf16 v[24:27], v[88:91], v[92:95], 0
    ds_read_b128 v[108:111], v2 offset:4224
    v_mfma_f32_16x16x32_bf16 v[28:31], v[80:83], v[92:95], 0
    s_waitcnt lgkmcnt(3)
    ds_read_b128 v[112:115], v3 offset:12672
    v_mfma_f32_16x16x32_bf16 v[36:39], v[80:83], v[96:99], 0
    s_barrier
    v_mfma_f32_16x16x32_bf16 v[32:35], v[88:91], v[96:99], 0
    s_waitcnt lgkmcnt(3)
    ds_read_b128 v[116:119], v2 offset:2112
    v_mfma_f32_16x16x32_bf16 v[40:43], v[88:91], v[100:103], 0
    ds_read_b128 v[120:123], v2 offset:0
    v_mfma_f32_16x16x32_bf16 v[44:47], v[80:83], v[100:103], 0
    s_waitcnt lgkmcnt(4)
    s_barrier
    v_mfma_f32_16x16x32_bf16 v[52:55], v[80:83], v[104:107], 0
    ds_read_b64_tr_b16 v[124:125], v6 offset:8192
    v_mfma_f32_16x16x32_bf16 v[48:51], v[88:91], v[104:107], 0
    s_waitcnt lgkmcnt(4)
    ds_read_b64_tr_b16 v[126:127], v6 offset:9216
    v_mfma_f32_16x16x32_bf16 v[56:59], v[88:91], v[108:111], 0
    ds_read_b64_tr_b16 v[128:129], v4 offset:8192
    v_mfma_f32_16x16x32_bf16 v[60:63], v[80:83], v[108:111], 0
    s_waitcnt lgkmcnt(4)
    ds_read_b64_tr_b16 v[130:131], v4 offset:9216
    v_mfma_f32_16x16x32_bf16 v[68:71], v[80:83], v[116:119], 0
    ds_read_b128 v[132:135], v3 offset:14784
    v_mfma_f32_16x16x32_bf16 v[64:67], v[88:91], v[116:119], 0
    s_waitcnt lgkmcnt(5)
    ds_read_b128 v[136:139], v2 offset:14848
    v_mfma_f32_16x16x32_bf16 v[72:75], v[88:91], v[120:123], 0
    ds_read_b128 v[140:143], v2 offset:12736
    v_mfma_f32_16x16x32_bf16 v[76:79], v[80:83], v[120:123], 0
    s_waitcnt lgkmcnt(5)
    ds_read_b128 v[144:147], v2 offset:10624
    v_mfma_f32_16x16x32_bf16 v[20:23], v[124:127], v[92:95], v[20:23]
    ds_read_b128 v[148:151], v2 offset:8512
    v_mfma_f32_16x16x32_bf16 v[28:31], v[124:127], v[96:99], v[28:31]
    ds_read_b128 v[152:155], v2 offset:6400
    v_mfma_f32_16x16x32_bf16 v[36:39], v[124:127], v[100:103], v[36:39]
    ds_read_b128 v[156:159], v2 offset:4288
    v_mfma_f32_16x16x32_bf16 v[44:47], v[124:127], v[104:107], v[44:47]
    ds_read_b128 v[160:163], v2 offset:2176
    v_mfma_f32_16x16x32_bf16 v[52:55], v[124:127], v[108:111], v[52:55]
    s_barrier
    v_mfma_f32_16x16x32_bf16 v[60:63], v[124:127], v[116:119], v[60:63]
    ds_read_b64_tr_b16 v[164:165], v6 offset:16384
    v_mfma_f32_16x16x32_bf16 v[68:71], v[124:127], v[120:123], v[68:71]
    s_waitcnt lgkmcnt(7)
    ds_read_b64_tr_b16 v[166:167], v6 offset:17408
    v_mfma_f32_16x16x32_bf16 v[76:79], v[124:127], v[132:135], v[76:79]
    ds_read_b64_tr_b16 v[168:169], v4 offset:16384
    v_mfma_f32_16x16x32_bf16 v[16:19], v[128:131], v[92:95], v[16:19]
    ds_read_b64_tr_b16 v[170:171], v4 offset:17408
    v_mfma_f32_16x16x32_bf16 v[24:27], v[128:131], v[96:99], v[24:27]
    ds_read_b128 v[172:175], v2 offset:64
    v_mfma_f32_16x16x32_bf16 v[32:35], v[128:131], v[100:103], v[32:35]
    ds_read_b128 v[176:179], v3 offset:12736
    v_mfma_f32_16x16x32_bf16 v[40:43], v[128:131], v[104:107], v[40:43]
    ds_read_b128 v[180:183], v3 offset:14848
    v_mfma_f32_16x16x32_bf16 v[48:51], v[128:131], v[108:111], v[48:51]
    v_mfma_f32_16x16x32_bf16 v[56:59], v[128:131], v[116:119], v[56:59]
    s_barrier
    v_mfma_f32_16x16x32_bf16 v[64:67], v[128:131], v[120:123], v[64:67]
    ds_read_b64_tr_b16 v[184:185], v6 offset:24576
    v_mfma_f32_16x16x32_bf16 v[72:75], v[128:131], v[132:135], v[72:75]
    s_waitcnt lgkmcnt(6)
    ds_read_b64_tr_b16 v[186:187], v6 offset:25600
    v_mfma_f32_16x16x32_bf16 v[20:23], v[164:167], v[96:99], v[20:23]
    ds_read_b64_tr_b16 v[188:189], v4 offset:24576
    v_mfma_f32_16x16x32_bf16 v[28:31], v[164:167], v[100:103], v[28:31]
    s_barrier
    v_mfma_f32_16x16x32_bf16 v[36:39], v[164:167], v[104:107], v[36:39]
    ds_read_b64_tr_b16 v[192:193], v6 offset:32768
    v_mfma_f32_16x16x32_bf16 v[44:47], v[164:167], v[108:111], v[44:47]
    ds_read_b64_tr_b16 v[194:195], v6 offset:33792
    v_mfma_f32_16x16x32_bf16 v[52:55], v[164:167], v[116:119], v[52:55]
    ds_read_b64_tr_b16 v[196:197], v4 offset:32768
    v_mfma_f32_16x16x32_bf16 v[60:63], v[164:167], v[120:123], v[60:63]
    s_barrier
    v_mfma_f32_16x16x32_bf16 v[68:71], v[164:167], v[132:135], v[68:71]
    ds_read_b64_tr_b16 v[200:201], v6 offset:40960
    v_mfma_f32_16x16x32_bf16 v[76:79], v[164:167], v[112:115], v[76:79]
    s_waitcnt lgkmcnt(6)
    ds_read_b64_tr_b16 v[202:203], v6 offset:41984
    v_mfma_f32_16x16x32_bf16 v[16:19], v[168:171], v[96:99], v[16:19]
    ds_read_b64_tr_b16 v[204:205], v4 offset:40960
    v_mfma_f32_16x16x32_bf16 v[24:27], v[168:171], v[100:103], v[24:27]
    ds_read_b64_tr_b16 v[206:207], v4 offset:41984
    v_mfma_f32_16x16x32_bf16 v[32:35], v[168:171], v[104:107], v[32:35]
    ds_read_b64_tr_b16 v[198:199], v4 offset:33792
    v_mfma_f32_16x16x32_bf16 v[40:43], v[168:171], v[108:111], v[40:43]
    ds_read_b64_tr_b16 v[190:191], v4 offset:25600
    v_mfma_f32_16x16x32_bf16 v[48:51], v[168:171], v[116:119], v[48:51]
    v_mfma_f32_16x16x32_bf16 v[56:59], v[168:171], v[120:123], v[56:59]
    v_mfma_f32_16x16x32_bf16 v[64:67], v[168:171], v[132:135], v[64:67]
    v_mfma_f32_16x16x32_bf16 v[72:75], v[168:171], v[112:115], v[72:75]
    s_waitcnt lgkmcnt(5)
    v_mfma_f32_16x16x32_bf16 v[20:23], v[184:187], v[136:139], v[20:23]
    v_mfma_f32_16x16x32_bf16 v[20:23], v[192:195], v[140:143], v[20:23]
    s_waitcnt lgkmcnt(3)
    v_mfma_f32_16x16x32_bf16 v[20:23], v[200:203], v[144:147], v[20:23]
    s_waitcnt lgkmcnt(2)
    v_mfma_f32_16x16x32_bf16 v[16:19], v[204:207], v[144:147], v[16:19]
    s_waitcnt lgkmcnt(1)
    v_mfma_f32_16x16x32_bf16 v[16:19], v[196:199], v[140:143], v[16:19]
    s_waitcnt lgkmcnt(0)
    v_mfma_f32_16x16x32_bf16 v[16:19], v[188:191], v[136:139], v[16:19]
    v_mfma_f32_16x16x32_bf16 v[24:27], v[188:191], v[140:143], v[24:27]
    v_mfma_f32_16x16x32_bf16 v[24:27], v[196:199], v[144:147], v[24:27]
    v_mfma_f32_16x16x32_bf16 v[24:27], v[204:207], v[148:151], v[24:27]
    v_mfma_f32_16x16x32_bf16 v[28:31], v[200:203], v[148:151], v[28:31]
    v_mfma_f32_16x16x32_bf16 v[28:31], v[192:195], v[144:147], v[28:31]
    v_mfma_f32_16x16x32_bf16 v[28:31], v[184:187], v[140:143], v[28:31]
    v_mfma_f32_16x16x32_bf16 v[36:39], v[184:187], v[144:147], v[36:39]
    v_mfma_f32_16x16x32_bf16 v[36:39], v[192:195], v[148:151], v[36:39]
    v_mfma_f32_16x16x32_bf16 v[36:39], v[200:203], v[152:155], v[36:39]
    v_mfma_f32_16x16x32_bf16 v[32:35], v[204:207], v[152:155], v[32:35]
    v_mfma_f32_16x16x32_bf16 v[32:35], v[196:199], v[148:151], v[32:35]
    v_mfma_f32_16x16x32_bf16 v[32:35], v[188:191], v[144:147], v[32:35]
    v_mfma_f32_16x16x32_bf16 v[40:43], v[188:191], v[148:151], v[40:43]
    v_mfma_f32_16x16x32_bf16 v[40:43], v[196:199], v[152:155], v[40:43]
    v_mfma_f32_16x16x32_bf16 v[40:43], v[204:207], v[156:159], v[40:43]
    v_mfma_f32_16x16x32_bf16 v[44:47], v[200:203], v[156:159], v[44:47]
    v_mfma_f32_16x16x32_bf16 v[44:47], v[192:195], v[152:155], v[44:47]
    v_mfma_f32_16x16x32_bf16 v[44:47], v[184:187], v[148:151], v[44:47]
    v_mfma_f32_16x16x32_bf16 v[52:55], v[184:187], v[152:155], v[52:55]
    v_mfma_f32_16x16x32_bf16 v[52:55], v[192:195], v[156:159], v[52:55]
    v_mfma_f32_16x16x32_bf16 v[52:55], v[200:203], v[160:163], v[52:55]
    s_barrier
    v_mfma_f32_16x16x32_bf16 v[48:51], v[204:207], v[160:163], v[48:51]
    ds_read_b128 v[208:211], v2 offset:31936
    v_mfma_f32_16x16x32_bf16 v[48:51], v[196:199], v[156:159], v[48:51]
    ds_read_b64_tr_b16 v[212:213], v7 offset:0
    v_mfma_f32_16x16x32_bf16 v[48:51], v[188:191], v[152:155], v[48:51]
    ds_read_b64_tr_b16 v[214:215], v7 offset:1024
    v_mfma_f32_16x16x32_bf16 v[56:59], v[188:191], v[156:159], v[56:59]
    ds_read_b128 v[216:219], v2 offset:29824
    v_mfma_f32_16x16x32_bf16 v[56:59], v[196:199], v[160:163], v[56:59]
    ds_read_b128 v[220:223], v2 offset:27712
    v_mfma_f32_16x16x32_bf16 v[56:59], v[204:207], v[172:175], v[56:59]
    ds_read_b64_tr_b16 v[224:225], v5 offset:0
    v_mfma_f32_16x16x32_bf16 v[60:63], v[200:203], v[172:175], v[60:63]
    s_barrier
    v_mfma_f32_16x16x32_bf16 v[60:63], v[192:195], v[160:163], v[60:63]
    ds_read_b64_tr_b16 v[228:229], v7 offset:8192
    v_mfma_f32_16x16x32_bf16 v[60:63], v[184:187], v[156:159], v[60:63]
    ds_read_b64_tr_b16 v[230:231], v7 offset:9216
    v_mfma_f32_16x16x32_bf16 v[68:71], v[184:187], v[160:163], v[68:71]
    ds_read_b64_tr_b16 v[232:233], v5 offset:8192
    v_mfma_f32_16x16x32_bf16 v[68:71], v[192:195], v[172:175], v[68:71]
    s_barrier
    v_mfma_f32_16x16x32_bf16 v[68:71], v[200:203], v[180:183], v[68:71]
    ds_read_b64_tr_b16 v[236:237], v7 offset:16384
    v_mfma_f32_16x16x32_bf16 v[64:67], v[204:207], v[180:183], v[64:67]
    ds_read_b64_tr_b16 v[238:239], v7 offset:17408
    v_mfma_f32_16x16x32_bf16 v[64:67], v[196:199], v[172:175], v[64:67]
    ds_read_b64_tr_b16 v[240:241], v5 offset:16384
    v_mfma_f32_16x16x32_bf16 v[64:67], v[188:191], v[160:163], v[64:67]
    ds_read_b64_tr_b16 v[242:243], v5 offset:17408
    v_mfma_f32_16x16x32_bf16 v[72:75], v[188:191], v[172:175], v[72:75]
    ds_read_b64_tr_b16 v[234:235], v5 offset:9216
    v_mfma_f32_16x16x32_bf16 v[72:75], v[196:199], v[180:183], v[72:75]
    ds_read_b64_tr_b16 v[226:227], v5 offset:1024
    v_mfma_f32_16x16x32_bf16 v[72:75], v[204:207], v[176:179], v[72:75]
    ds_read_b128 v[244:247], v2 offset:25600
    v_mfma_f32_16x16x32_bf16 v[76:79], v[200:203], v[176:179], v[76:79]
    ds_read_b128 v[84:87], v2 offset:23488
    v_mfma_f32_16x16x32_bf16 v[76:79], v[192:195], v[180:183], v[76:79]
    ds_read_b128 v[88:91], v2 offset:21376
    v_mfma_f32_16x16x32_bf16 v[76:79], v[184:187], v[172:175], v[76:79]
    s_waitcnt lgkmcnt(8)
    ds_read_b128 v[80:83], v2 offset:19264
    v_mfma_f32_16x16x32_bf16 v[20:23], v[212:215], v[208:211], v[20:23]
    ds_read_b128 v[124:127], v2 offset:17152
    v_mfma_f32_16x16x32_bf16 v[20:23], v[228:231], v[216:219], v[20:23]
    s_waitcnt lgkmcnt(8)
    ds_read_b128 v[92:95], v3 offset:31936
    v_mfma_f32_16x16x32_bf16 v[20:23], v[236:239], v[220:223], v[20:23]
    s_waitcnt lgkmcnt(8)
    ds_read_b128 v[128:131], v3 offset:29824
    v_mfma_f32_16x16x32_bf16 v[16:19], v[240:243], v[220:223], v[16:19]
    s_waitcnt lgkmcnt(8)
    ds_read_b128 v[164:167], v2 offset:32000
    v_mfma_f32_16x16x32_bf16 v[16:19], v[232:235], v[216:219], v[16:19]
    s_waitcnt lgkmcnt(8)
    ds_read_b128 v[96:99], v2 offset:29888
    v_mfma_f32_16x16x32_bf16 v[16:19], v[224:227], v[208:211], v[16:19]
    ds_read_b128 v[100:103], v2 offset:27776
    v_mfma_f32_16x16x32_bf16 v[24:27], v[224:227], v[216:219], v[24:27]
    ds_read_b128 v[104:107], v2 offset:25664
    v_mfma_f32_16x16x32_bf16 v[24:27], v[232:235], v[220:223], v[24:27]
    s_waitcnt lgkmcnt(8)
    ds_read_b128 v[108:111], v2 offset:23552
    v_mfma_f32_16x16x32_bf16 v[24:27], v[240:243], v[244:247], v[24:27]
    ds_read_b128 v[116:119], v2 offset:21440
    v_mfma_f32_16x16x32_bf16 v[28:31], v[236:239], v[244:247], v[28:31]
    ds_read_b128 v[120:123], v2 offset:19328
    v_mfma_f32_16x16x32_bf16 v[28:31], v[228:231], v[220:223], v[28:31]
    ds_read_b128 v[132:135], v2 offset:17216
    v_mfma_f32_16x16x32_bf16 v[28:31], v[212:215], v[216:219], v[28:31]
    ds_read_b128 v[168:171], v3 offset:32000
    v_mfma_f32_16x16x32_bf16 v[36:39], v[212:215], v[220:223], v[36:39]
    ds_read_b128 v[112:115], v3 offset:29888
    v_mfma_f32_16x16x32_bf16 v[36:39], v[228:231], v[244:247], v[36:39]
    ds_read_b128 v[136:139], v2 offset:48960
    v_mfma_f32_16x16x32_bf16 v[36:39], v[236:239], v[84:87], v[36:39]
    ds_read_b128 v[140:143], v2 offset:46848
    v_mfma_f32_16x16x32_bf16 v[32:35], v[240:243], v[84:87], v[32:35]
    ds_read_b128 v[144:147], v2 offset:44736
    v_mfma_f32_16x16x32_bf16 v[32:35], v[232:235], v[244:247], v[32:35]
    v_mfma_f32_16x16x32_bf16 v[32:35], v[224:227], v[220:223], v[32:35]
    v_mfma_f32_16x16x32_bf16 v[40:43], v[224:227], v[244:247], v[40:43]
    v_mfma_f32_16x16x32_bf16 v[40:43], v[232:235], v[84:87], v[40:43]
    v_mfma_f32_16x16x32_bf16 v[40:43], v[240:243], v[88:91], v[40:43]
    v_mfma_f32_16x16x32_bf16 v[44:47], v[236:239], v[88:91], v[44:47]
    v_mfma_f32_16x16x32_bf16 v[44:47], v[228:231], v[84:87], v[44:47]
    v_mfma_f32_16x16x32_bf16 v[44:47], v[212:215], v[244:247], v[44:47]
    v_mfma_f32_16x16x32_bf16 v[52:55], v[212:215], v[84:87], v[52:55]
    ds_read_b128 v[148:151], v2 offset:42624
    v_mfma_f32_16x16x32_bf16 v[52:55], v[228:231], v[88:91], v[52:55]
    s_waitcnt lgkmcnt(1)
    v_mfma_f32_16x16x32_bf16 v[52:55], v[236:239], v[80:83], v[52:55]
    v_mfma_f32_16x16x32_bf16 v[48:51], v[240:243], v[80:83], v[48:51]
    v_mfma_f32_16x16x32_bf16 v[48:51], v[232:235], v[88:91], v[48:51]
    v_mfma_f32_16x16x32_bf16 v[48:51], v[224:227], v[84:87], v[48:51]
    v_mfma_f32_16x16x32_bf16 v[56:59], v[224:227], v[88:91], v[56:59]
    ds_read_b128 v[152:155], v2 offset:40512
    v_mfma_f32_16x16x32_bf16 v[56:59], v[232:235], v[80:83], v[56:59]
    s_barrier
    v_mfma_f32_16x16x32_bf16 v[56:59], v[240:243], v[124:127], v[56:59]
    ds_read_b64_tr_b16 v[156:157], v7 offset:24576
    v_mfma_f32_16x16x32_bf16 v[60:63], v[236:239], v[124:127], v[60:63]
    ds_read_b64_tr_b16 v[158:159], v7 offset:25600
    v_mfma_f32_16x16x32_bf16 v[60:63], v[228:231], v[80:83], v[60:63]
    ds_read_b64_tr_b16 v[160:161], v7 offset:32768
    v_mfma_f32_16x16x32_bf16 v[60:63], v[212:215], v[88:91], v[60:63]
    ds_read_b64_tr_b16 v[162:163], v7 offset:33792
    v_mfma_f32_16x16x32_bf16 v[68:71], v[212:215], v[80:83], v[68:71]
    ds_read_b64_tr_b16 v[188:189], v6 offset:0
    v_mfma_f32_16x16x32_bf16 v[68:71], v[228:231], v[124:127], v[68:71]
    ds_read_b64_tr_b16 v[190:191], v6 offset:1024
    v_mfma_f32_16x16x32_bf16 v[68:71], v[236:239], v[92:95], v[68:71]
    ds_read_b64_tr_b16 v[196:197], v4 offset:0
    v_mfma_f32_16x16x32_bf16 v[64:67], v[240:243], v[92:95], v[64:67]
    ds_read_b64_tr_b16 v[198:199], v4 offset:1024
    v_mfma_f32_16x16x32_bf16 v[64:67], v[232:235], v[124:127], v[64:67]
    ds_read_b64_tr_b16 v[204:205], v5 offset:32768
    v_mfma_f32_16x16x32_bf16 v[64:67], v[224:227], v[80:83], v[64:67]
    ds_read_b64_tr_b16 v[206:207], v5 offset:33792
    v_mfma_f32_16x16x32_bf16 v[72:75], v[224:227], v[124:127], v[72:75]
    ds_read_b64_tr_b16 v[200:201], v5 offset:24576
    v_mfma_f32_16x16x32_bf16 v[72:75], v[232:235], v[92:95], v[72:75]
    ds_read_b64_tr_b16 v[202:203], v5 offset:25600
    v_mfma_f32_16x16x32_bf16 v[72:75], v[240:243], v[128:131], v[72:75]
    ds_read_b128 v[176:179], v2 offset:38400
    v_mfma_f32_16x16x32_bf16 v[76:79], v[236:239], v[128:131], v[76:79]
    ds_read_b128 v[192:195], v2 offset:36288
    v_mfma_f32_16x16x32_bf16 v[76:79], v[228:231], v[92:95], v[76:79]
    v_mfma_f32_16x16x32_bf16 v[76:79], v[212:215], v[124:127], v[76:79]
    s_waitcnt lgkmcnt(7)
    v_mfma_f32_16x16x32_bf16 v[20:23], v[156:159], v[164:167], v[20:23]
    ds_read_b128 v[180:183], v2 offset:34176
    v_mfma_f32_16x16x32_bf16 v[20:23], v[160:163], v[96:99], v[20:23]
    v_mfma_f32_16x16x32_bf16 v[20:23], v[188:191], v[100:103], v[20:23]
    s_waitcnt lgkmcnt(5)
    v_mfma_f32_16x16x32_bf16 v[16:19], v[196:199], v[100:103], v[16:19]
    v_mfma_f32_16x16x32_bf16 v[16:19], v[204:207], v[96:99], v[16:19]
    s_waitcnt lgkmcnt(3)
    ds_read_b128 v[184:187], v3 offset:48960
    v_mfma_f32_16x16x32_bf16 v[16:19], v[200:203], v[164:167], v[16:19]
    ds_read_b128 v[172:175], v3 offset:46848
    v_mfma_f32_16x16x32_bf16 v[24:27], v[200:203], v[96:99], v[24:27]
    ds_read_b128 v[208:211], v2 offset:49024
    v_mfma_f32_16x16x32_bf16 v[24:27], v[204:207], v[100:103], v[24:27]
    ds_read_b128 v[216:219], v2 offset:46912
    v_mfma_f32_16x16x32_bf16 v[24:27], v[196:199], v[104:107], v[24:27]
    ds_read_b128 v[220:223], v2 offset:44800
    v_mfma_f32_16x16x32_bf16 v[28:31], v[188:191], v[104:107], v[28:31]
    v_mfma_f32_16x16x32_bf16 v[28:31], v[160:163], v[100:103], v[28:31]
    v_mfma_f32_16x16x32_bf16 v[28:31], v[156:159], v[96:99], v[28:31]
    v_mfma_f32_16x16x32_bf16 v[36:39], v[156:159], v[100:103], v[36:39]
    v_mfma_f32_16x16x32_bf16 v[36:39], v[160:163], v[104:107], v[36:39]
    v_mfma_f32_16x16x32_bf16 v[36:39], v[188:191], v[108:111], v[36:39]
    v_mfma_f32_16x16x32_bf16 v[32:35], v[196:199], v[108:111], v[32:35]
    v_mfma_f32_16x16x32_bf16 v[32:35], v[204:207], v[104:107], v[32:35]
    v_mfma_f32_16x16x32_bf16 v[32:35], v[200:203], v[100:103], v[32:35]
    v_mfma_f32_16x16x32_bf16 v[40:43], v[200:203], v[104:107], v[40:43]
    v_mfma_f32_16x16x32_bf16 v[40:43], v[204:207], v[108:111], v[40:43]
    v_mfma_f32_16x16x32_bf16 v[40:43], v[196:199], v[116:119], v[40:43]
    v_mfma_f32_16x16x32_bf16 v[44:47], v[188:191], v[116:119], v[44:47]
    v_mfma_f32_16x16x32_bf16 v[44:47], v[160:163], v[108:111], v[44:47]
    v_mfma_f32_16x16x32_bf16 v[44:47], v[156:159], v[104:107], v[44:47]
    v_mfma_f32_16x16x32_bf16 v[52:55], v[156:159], v[108:111], v[52:55]
    ds_read_b128 v[244:247], v2 offset:42688
    v_mfma_f32_16x16x32_bf16 v[52:55], v[160:163], v[116:119], v[52:55]
    v_mfma_f32_16x16x32_bf16 v[52:55], v[188:191], v[120:123], v[52:55]
    v_mfma_f32_16x16x32_bf16 v[48:51], v[196:199], v[120:123], v[48:51]
    v_mfma_f32_16x16x32_bf16 v[48:51], v[204:207], v[116:119], v[48:51]
    v_mfma_f32_16x16x32_bf16 v[48:51], v[200:203], v[108:111], v[48:51]
    ds_read_b128 v[84:87], v2 offset:40576
    v_mfma_f32_16x16x32_bf16 v[56:59], v[200:203], v[116:119], v[56:59]
    ds_read_b128 v[88:91], v2 offset:38464
    v_mfma_f32_16x16x32_bf16 v[56:59], v[204:207], v[120:123], v[56:59]
    s_barrier
    v_mfma_f32_16x16x32_bf16 v[56:59], v[196:199], v[132:135], v[56:59]
    ds_read_b64_tr_b16 v[80:81], v6 offset:8192
    v_mfma_f32_16x16x32_bf16 v[60:63], v[188:191], v[132:135], v[60:63]
    ds_read_b64_tr_b16 v[82:83], v6 offset:9216
    v_mfma_f32_16x16x32_bf16 v[60:63], v[160:163], v[120:123], v[60:63]
    ds_read_b64_tr_b16 v[224:225], v6 offset:16384
    v_mfma_f32_16x16x32_bf16 v[60:63], v[156:159], v[116:119], v[60:63]
    ds_read_b64_tr_b16 v[226:227], v6 offset:17408
    v_mfma_f32_16x16x32_bf16 v[68:71], v[156:159], v[120:123], v[68:71]
    ds_read_b64_tr_b16 v[232:233], v6 offset:24576
    v_mfma_f32_16x16x32_bf16 v[68:71], v[160:163], v[132:135], v[68:71]
    ds_read_b64_tr_b16 v[234:235], v6 offset:25600
    v_mfma_f32_16x16x32_bf16 v[68:71], v[188:191], v[168:171], v[68:71]
    ds_read_b64_tr_b16 v[240:241], v4 offset:24576
    v_mfma_f32_16x16x32_bf16 v[64:67], v[196:199], v[168:171], v[64:67]
    ds_read_b64_tr_b16 v[242:243], v4 offset:25600
    v_mfma_f32_16x16x32_bf16 v[64:67], v[204:207], v[132:135], v[64:67]
    ds_read_b64_tr_b16 v[236:237], v4 offset:16384
    v_mfma_f32_16x16x32_bf16 v[64:67], v[200:203], v[120:123], v[64:67]
    ds_read_b64_tr_b16 v[238:239], v4 offset:17408
    v_mfma_f32_16x16x32_bf16 v[72:75], v[200:203], v[132:135], v[72:75]
    ds_read_b64_tr_b16 v[128:129], v4 offset:8192
    v_mfma_f32_16x16x32_bf16 v[72:75], v[204:207], v[168:171], v[72:75]
    ds_read_b64_tr_b16 v[130:131], v4 offset:9216
    v_mfma_f32_16x16x32_bf16 v[72:75], v[196:199], v[112:115], v[72:75]
    ds_read_b128 v[228:231], v2 offset:36352
    v_mfma_f32_16x16x32_bf16 v[76:79], v[188:191], v[112:115], v[76:79]
    ds_read_b128 v[92:95], v2 offset:34240
    v_mfma_f32_16x16x32_bf16 v[76:79], v[160:163], v[168:171], v[76:79]
    v_mfma_f32_16x16x32_bf16 v[76:79], v[156:159], v[132:135], v[76:79]
    s_waitcnt lgkmcnt(7)
    v_mfma_f32_16x16x32_bf16 v[20:23], v[80:83], v[136:139], v[20:23]
    v_mfma_f32_16x16x32_bf16 v[20:23], v[224:227], v[140:143], v[20:23]
    v_mfma_f32_16x16x32_bf16 v[20:23], v[232:235], v[144:147], v[20:23]
    s_waitcnt lgkmcnt(4)
    v_mfma_f32_16x16x32_bf16 v[16:19], v[240:243], v[144:147], v[16:19]
    v_mfma_f32_16x16x32_bf16 v[16:19], v[236:239], v[140:143], v[16:19]
    s_waitcnt lgkmcnt(2)
    v_mfma_f32_16x16x32_bf16 v[16:19], v[128:131], v[136:139], v[16:19]
    v_mfma_f32_16x16x32_bf16 v[24:27], v[128:131], v[140:143], v[24:27]
    v_mfma_f32_16x16x32_bf16 v[24:27], v[236:239], v[144:147], v[24:27]
    v_mfma_f32_16x16x32_bf16 v[24:27], v[240:243], v[148:151], v[24:27]
    v_mfma_f32_16x16x32_bf16 v[28:31], v[232:235], v[148:151], v[28:31]
    v_mfma_f32_16x16x32_bf16 v[28:31], v[224:227], v[144:147], v[28:31]
    v_mfma_f32_16x16x32_bf16 v[28:31], v[80:83], v[140:143], v[28:31]
    v_mfma_f32_16x16x32_bf16 v[36:39], v[80:83], v[144:147], v[36:39]
    v_mfma_f32_16x16x32_bf16 v[36:39], v[224:227], v[148:151], v[36:39]
    v_mfma_f32_16x16x32_bf16 v[36:39], v[232:235], v[152:155], v[36:39]
    v_mfma_f32_16x16x32_bf16 v[32:35], v[240:243], v[152:155], v[32:35]
    v_mfma_f32_16x16x32_bf16 v[32:35], v[236:239], v[148:151], v[32:35]
    v_mfma_f32_16x16x32_bf16 v[32:35], v[128:131], v[144:147], v[32:35]
    v_mfma_f32_16x16x32_bf16 v[40:43], v[128:131], v[148:151], v[40:43]
    v_mfma_f32_16x16x32_bf16 v[40:43], v[236:239], v[152:155], v[40:43]
    v_mfma_f32_16x16x32_bf16 v[40:43], v[240:243], v[176:179], v[40:43]
    v_mfma_f32_16x16x32_bf16 v[44:47], v[232:235], v[176:179], v[44:47]
    v_mfma_f32_16x16x32_bf16 v[44:47], v[224:227], v[152:155], v[44:47]
    v_mfma_f32_16x16x32_bf16 v[44:47], v[80:83], v[148:151], v[44:47]
    v_mfma_f32_16x16x32_bf16 v[52:55], v[80:83], v[152:155], v[52:55]
    v_mfma_f32_16x16x32_bf16 v[52:55], v[224:227], v[176:179], v[52:55]
    v_mfma_f32_16x16x32_bf16 v[52:55], v[232:235], v[192:195], v[52:55]
    v_mfma_f32_16x16x32_bf16 v[48:51], v[240:243], v[192:195], v[48:51]
    v_mfma_f32_16x16x32_bf16 v[48:51], v[236:239], v[176:179], v[48:51]
    v_mfma_f32_16x16x32_bf16 v[48:51], v[128:131], v[152:155], v[48:51]
    v_mfma_f32_16x16x32_bf16 v[56:59], v[128:131], v[176:179], v[56:59]
    v_mfma_f32_16x16x32_bf16 v[56:59], v[236:239], v[192:195], v[56:59]
    s_barrier
    v_mfma_f32_16x16x32_bf16 v[56:59], v[240:243], v[180:183], v[56:59]
    ds_read_b64_tr_b16 v[212:213], v6 offset:32768
    v_mfma_f32_16x16x32_bf16 v[60:63], v[232:235], v[180:183], v[60:63]
    ds_read_b64_tr_b16 v[214:215], v6 offset:33792
    v_mfma_f32_16x16x32_bf16 v[60:63], v[224:227], v[192:195], v[60:63]
    ds_read_b64_tr_b16 v[124:125], v6 offset:40960
    v_mfma_f32_16x16x32_bf16 v[60:63], v[80:83], v[176:179], v[60:63]
    ds_read_b64_tr_b16 v[126:127], v6 offset:41984
    v_mfma_f32_16x16x32_bf16 v[68:71], v[80:83], v[192:195], v[68:71]
    ds_read_b64_tr_b16 v[164:165], v7 offset:0
    v_mfma_f32_16x16x32_bf16 v[68:71], v[224:227], v[180:183], v[68:71]
    ds_read_b64_tr_b16 v[166:167], v7 offset:1024
    v_mfma_f32_16x16x32_bf16 v[68:71], v[232:235], v[184:187], v[68:71]
    ds_read_b64_tr_b16 v[96:97], v5 offset:0
    v_mfma_f32_16x16x32_bf16 v[64:67], v[240:243], v[184:187], v[64:67]
    ds_read_b64_tr_b16 v[98:99], v5 offset:1024
    v_mfma_f32_16x16x32_bf16 v[64:67], v[236:239], v[180:183], v[64:67]
    ds_read_b64_tr_b16 v[100:101], v4 offset:40960
    v_mfma_f32_16x16x32_bf16 v[64:67], v[128:131], v[192:195], v[64:67]
    ds_read_b64_tr_b16 v[102:103], v4 offset:41984
    v_mfma_f32_16x16x32_bf16 v[72:75], v[128:131], v[180:183], v[72:75]
    ds_read_b64_tr_b16 v[104:105], v4 offset:32768
    v_mfma_f32_16x16x32_bf16 v[72:75], v[236:239], v[184:187], v[72:75]
    ds_read_b64_tr_b16 v[106:107], v4 offset:33792
    v_mfma_f32_16x16x32_bf16 v[72:75], v[240:243], v[172:175], v[72:75]
    v_mfma_f32_16x16x32_bf16 v[76:79], v[232:235], v[172:175], v[76:79]
    s_barrier
    v_mfma_f32_16x16x32_bf16 v[76:79], v[224:227], v[184:187], v[76:79]
    ds_read_b128 v[108:111], v2 offset:14912
    v_mfma_f32_16x16x32_bf16 v[76:79], v[80:83], v[180:183], v[76:79]
    s_waitcnt lgkmcnt(6)
    ds_read_b128 v[116:119], v2 offset:12800
    v_mfma_f32_16x16x32_bf16 v[20:23], v[212:215], v[208:211], v[20:23]
    ds_read_b128 v[120:123], v2 offset:10688
    v_mfma_f32_16x16x32_bf16 v[20:23], v[124:127], v[216:219], v[20:23]
    ds_read_b128 v[200:203], v2 offset:8576
    v_mfma_f32_16x16x32_bf16 v[20:23], v[164:167], v[220:223], v[20:23]
    s_waitcnt lgkmcnt(6)
    ds_read_b128 v[204:207], v2 offset:14976
    v_mfma_f32_16x16x32_bf16 v[16:19], v[96:99], v[220:223], v[16:19]
    ds_read_b128 v[196:199], v2 offset:12864
    v_mfma_f32_16x16x32_bf16 v[16:19], v[100:103], v[216:219], v[16:19]
    s_waitcnt lgkmcnt(6)
    ds_read_b128 v[188:191], v2 offset:10752
    v_mfma_f32_16x16x32_bf16 v[16:19], v[104:107], v[208:211], v[16:19]
    ds_read_b128 v[112:115], v2 offset:8640
    v_mfma_f32_16x16x32_bf16 v[24:27], v[104:107], v[216:219], v[24:27]
    ds_read_b128 v[160:163], v2 offset:6464
    v_mfma_f32_16x16x32_bf16 v[24:27], v[100:103], v[220:223], v[24:27]
    ds_read_b128 v[168:171], v2 offset:6528
    v_mfma_f32_16x16x32_bf16 v[24:27], v[96:99], v[244:247], v[24:27]
    ds_read_b128 v[156:159], v2 offset:4352
    v_mfma_f32_16x16x32_bf16 v[28:31], v[164:167], v[244:247], v[28:31]
    ds_read_b128 v[132:135], v2 offset:4416
    v_mfma_f32_16x16x32_bf16 v[28:31], v[124:127], v[220:223], v[28:31]
    ds_read_b128 v[136:139], v2 offset:2240
    v_mfma_f32_16x16x32_bf16 v[28:31], v[212:215], v[216:219], v[28:31]
    ds_read_b128 v[140:143], v2 offset:2304
    v_mfma_f32_16x16x32_bf16 v[36:39], v[212:215], v[220:223], v[36:39]
    v_mfma_f32_16x16x32_bf16 v[36:39], v[124:127], v[244:247], v[36:39]
    v_mfma_f32_16x16x32_bf16 v[36:39], v[164:167], v[84:87], v[36:39]
    s_barrier
    v_mfma_f32_16x16x32_bf16 v[32:35], v[96:99], v[84:87], v[32:35]
    ds_read_b64_tr_b16 v[144:145], v7 offset:8192
    v_mfma_f32_16x16x32_bf16 v[32:35], v[100:103], v[244:247], v[32:35]
    ds_read_b64_tr_b16 v[146:147], v7 offset:9216
    v_mfma_f32_16x16x32_bf16 v[32:35], v[104:107], v[220:223], v[32:35]
    ds_read_b64_tr_b16 v[148:149], v5 offset:8192
    v_mfma_f32_16x16x32_bf16 v[40:43], v[104:107], v[244:247], v[40:43]
    ds_read_b64_tr_b16 v[150:151], v5 offset:9216
    v_mfma_f32_16x16x32_bf16 v[40:43], v[100:103], v[84:87], v[40:43]
    s_barrier
    v_mfma_f32_16x16x32_bf16 v[40:43], v[96:99], v[88:91], v[40:43]
    ds_read_b64_tr_b16 v[152:153], v7 offset:16384
    v_mfma_f32_16x16x32_bf16 v[44:47], v[164:167], v[88:91], v[44:47]
    ds_read_b64_tr_b16 v[154:155], v7 offset:17408
    v_mfma_f32_16x16x32_bf16 v[44:47], v[124:127], v[84:87], v[44:47]
    ds_read_b64_tr_b16 v[176:177], v5 offset:16384
    v_mfma_f32_16x16x32_bf16 v[44:47], v[212:215], v[244:247], v[44:47]
    ds_read_b64_tr_b16 v[178:179], v5 offset:17408
    v_mfma_f32_16x16x32_bf16 v[52:55], v[212:215], v[84:87], v[52:55]
    s_barrier
    v_mfma_f32_16x16x32_bf16 v[52:55], v[124:127], v[88:91], v[52:55]
    ds_read_b64_tr_b16 v[192:193], v7 offset:24576
    v_mfma_f32_16x16x32_bf16 v[52:55], v[164:167], v[228:231], v[52:55]
    ds_read_b64_tr_b16 v[194:195], v7 offset:25600
    v_mfma_f32_16x16x32_bf16 v[48:51], v[96:99], v[228:231], v[48:51]
    ds_read_b64_tr_b16 v[128:129], v5 offset:24576
    v_mfma_f32_16x16x32_bf16 v[48:51], v[100:103], v[88:91], v[48:51]
    ds_read_b64_tr_b16 v[130:131], v5 offset:25600
    v_mfma_f32_16x16x32_bf16 v[48:51], v[104:107], v[84:87], v[48:51]
    s_barrier
    v_mfma_f32_16x16x32_bf16 v[56:59], v[104:107], v[88:91], v[56:59]
    ds_read_b64_tr_b16 v[236:237], v7 offset:32768
    v_mfma_f32_16x16x32_bf16 v[56:59], v[100:103], v[228:231], v[56:59]
    ds_read_b64_tr_b16 v[238:239], v7 offset:33792
    v_mfma_f32_16x16x32_bf16 v[56:59], v[96:99], v[92:95], v[56:59]
    ds_read_b64_tr_b16 v[240:241], v5 offset:32768
    v_mfma_f32_16x16x32_bf16 v[60:63], v[164:167], v[92:95], v[60:63]
    ds_read_b64_tr_b16 v[242:243], v5 offset:33792
    v_mfma_f32_16x16x32_bf16 v[60:63], v[124:127], v[228:231], v[60:63]
    s_barrier
    v_mfma_f32_16x16x32_bf16 v[60:63], v[212:215], v[88:91], v[60:63]
    s_waitcnt lgkmcnt(6)
    ds_read_b64_tr_b16 v[232:233], v6 offset:0
    v_mfma_f32_16x16x32_bf16 v[20:23], v[144:147], v[108:111], v[20:23]
    ds_read_b64_tr_b16 v[234:235], v6 offset:1024
    v_mfma_f32_16x16x32_bf16 v[20:23], v[152:155], v[116:119], v[20:23]
    ds_read_b64_tr_b16 v[172:173], v4 offset:0
    v_mfma_f32_16x16x32_bf16 v[20:23], v[192:195], v[120:123], v[20:23]
    s_waitcnt lgkmcnt(7)
    ds_read_b64_tr_b16 v[174:175], v4 offset:1024
    v_mfma_f32_16x16x32_bf16 v[16:19], v[128:131], v[120:123], v[16:19]
    s_barrier
    v_mfma_f32_16x16x32_bf16 v[16:19], v[176:179], v[116:119], v[16:19]
    ds_read_b64_tr_b16 v[224:225], v6 offset:8192
    v_mfma_f32_16x16x32_bf16 v[16:19], v[148:151], v[108:111], v[16:19]
    ds_read_b64_tr_b16 v[226:227], v6 offset:9216
    v_mfma_f32_16x16x32_bf16 v[24:27], v[148:151], v[116:119], v[24:27]
    ds_read_b64_tr_b16 v[184:185], v4 offset:8192
    v_mfma_f32_16x16x32_bf16 v[24:27], v[176:179], v[120:123], v[24:27]
    ds_read_b64_tr_b16 v[186:187], v4 offset:9216
    v_mfma_f32_16x16x32_bf16 v[24:27], v[128:131], v[200:203], v[24:27]
    ds_read_b128 v[80:83], v2 offset:128
    v_mfma_f32_16x16x32_bf16 v[28:31], v[192:195], v[200:203], v[28:31]
L_pad0:
    s_cbranch_scc1 L_cpro
    ds_read_b128 v[180:183], v2 offset:192
    v_mfma_f32_16x16x32_bf16 v[28:31], v[152:155], v[120:123], v[28:31]
    ds_read_b128 v[208:211], v3 offset:49024
    v_mfma_f32_16x16x32_bf16 v[28:31], v[144:147], v[116:119], v[28:31]
    s_waitcnt lgkmcnt(7)
    ds_read_b128 v[216:219], v3 offset:14912
    v_mfma_f32_16x16x32_bf16 v[20:23], v[236:239], v[204:207], v[20:23]
    ds_read_b128 v[220:223], v3 offset:14976
    v_mfma_f32_16x16x32_bf16 v[16:19], v[240:243], v[204:207], v[16:19]
    ds_read_b128 v[244:247], v3 offset:46912
    v_mfma_f32_16x16x32_bf16 v[20:23], v[232:235], v[196:199], v[20:23]
    v_mfma_f32_16x16x32_bf16 v[16:19], v[172:175], v[196:199], v[16:19]
    s_waitcnt lgkmcnt(7)
    ds_read_b128 v[84:87], v3 offset:12800
    v_mfma_f32_16x16x32_bf16 v[20:23], v[224:227], v[188:191], v[20:23]
    s_waitcnt lgkmcnt(7)
    v_mfma_f32_16x16x32_bf16 v[16:19], v[184:187], v[188:191], v[16:19]
    s_nop 2
    v_mfma_f32_16x16x32_bf16 v[28:31], v[236:239], v[196:199], v[28:31]
    ds_read_b128 v[88:91], v3 offset:12864
    s_nop 0
    v_mfma_f32_16x16x32_bf16 v[28:31], v[232:235], v[188:191], v[28:31]
    v_mfma_f32_16x16x32_bf16 v[28:31], v[224:227], v[112:115], v[28:31]
    v_mul_f32 v16, s28, v16
    v_mul_f32 v17, s28, v17
    v_mfma_f32_16x16x32_bf16 v[24:27], v[184:187], v[112:115], v[24:27]
    v_mul_f32 v18, s28, v18
    v_mul_f32 v19, s28, v19
    v_mfma_f32_16x16x32_bf16 v[24:27], v[172:175], v[188:191], v[24:27]
    v_exp_f32 v16, v16
    v_mfma_f32_16x16x32_bf16 v[24:27], v[240:243], v[196:199], v[24:27]
    v_exp_f32 v17, v17
    v_exp_f32 v18, v18
    v_exp_f32 v19, v19
    v_pk_mul_f32 v[20:21], v[20:21], s[28:29] op_sel:[0,1] op_sel_hi:[1,1]
    v_pk_mul_f32 v[22:23], v[22:23], s[28:29] op_sel:[0,1] op_sel_hi:[1,1]
    v_pk_mul_f32 v[28:29], v[28:29], s[28:29] op_sel:[0,1] op_sel_hi:[1,1]
    v_pk_mul_f32 v[30:31], v[30:31], s[28:29] op_sel:[0,1] op_sel_hi:[1,1]
    v_pk_fma_f32 v[16:17], v[16:17], s[30:31], s[30:31] op_sel_hi:[1,0,0] clamp
    v_pk_fma_f32 v[18:19], v[18:19], s[30:31], s[30:31] op_sel_hi:[1,0,0] clamp
    v_mfma_f32_16x16x32_bf16 v[32:35], v[148:151], v[120:123], v[32:35]
    v_exp_f32 v20, v20
    v_mfma_f32_16x16x32_bf16 v[32:35], v[176:179], v[200:203], v[32:35]
    v_exp_f32 v21, v21
    v_mfma_f32_16x16x32_bf16 v[32:35], v[128:131], v[160:163], v[32:35]
    v_exp_f32 v22, v22
    v_mfma_f32_16x16x32_bf16 v[32:35], v[240:243], v[188:191], v[32:35]
    v_exp_f32 v23, v23
    v_mfma_f32_16x16x32_bf16 v[32:35], v[172:175], v[112:115], v[32:35]
    v_exp_f32 v28, v28
    v_mfma_f32_16x16x32_bf16 v[32:35], v[184:187], v[168:171], v[32:35]
    v_exp_f32 v29, v29
    v_exp_f32 v30, v30
    v_exp_f32 v31, v31
    v_pk_mul_f32 v[24:25], v[24:25], s[28:29] op_sel_hi:[1,0]
    v_pk_mul_f32 v[26:27], v[26:27], s[28:29] op_sel_hi:[1,0]
    v_pk_fma_f32 v[20:21], v[16:17], v[20:21], v[16:17]
    v_pk_fma_f32 v[22:23], v[18:19], v[22:23], v[18:19]
    v_pk_add_f32 v[16:17], v[16:17], s[30:31] op_sel:[0,1] op_sel_hi:[1,1] neg_lo:[1,0] neg_hi:[1,0]
    v_pk_add_f32 v[18:19], v[18:19], s[30:31] op_sel:[0,1] op_sel_hi:[1,1] neg_lo:[1,0] neg_hi:[1,0]
    v_mfma_f32_16x16x32_bf16 v[36:39], v[224:227], v[168:171], v[36:39]
    v_rcp_f32 v20, v20
    v_mfma_f32_16x16x32_bf16 v[36:39], v[232:235], v[112:115], v[36:39]
    v_rcp_f32 v21, v21
    v_mfma_f32_16x16x32_bf16 v[36:39], v[236:239], v[188:191], v[36:39]
    v_rcp_f32 v22, v22
    v_mfma_f32_16x16x32_bf16 v[36:39], v[192:195], v[160:163], v[36:39]
    v_rcp_f32 v23, v23
    v_mfma_f32_16x16x32_bf16 v[36:39], v[152:155], v[200:203], v[36:39]
    v_exp_f32 v24, v24
    v_mfma_f32_16x16x32_bf16 v[36:39], v[144:147], v[120:123], v[36:39]
    v_exp_f32 v25, v25
    v_exp_f32 v26, v26
    v_exp_f32 v27, v27
    v_pk_mul_f32 v[32:33], v[32:33], s[28:29] op_sel_hi:[1,0]
    v_pk_mul_f32 v[34:35], v[34:35], s[28:29] op_sel_hi:[1,0]
    v_pk_mul_f32 v[16:17], v[16:17], v[20:21]
    v_pk_mul_f32 v[18:19], v[18:19], v[22:23]
    v_pk_fma_f32 v[24:25], v[24:25], s[30:31], s[30:31] op_sel_hi:[1,0,0] clamp
    v_pk_fma_f32 v[26:27], v[26:27], s[30:31], s[30:31] op_sel_hi:[1,0,0] clamp
    v_pk_fma_f32 v[28:29], v[24:25], v[28:29], v[24:25]
    v_pk_fma_f32 v[30:31], v[26:27], v[30:31], v[26:27]
    v_pk_add_f32 v[24:25], v[24:25], s[30:31] op_sel:[0,1] op_sel_hi:[1,1] neg_lo:[1,0] neg_hi:[1,0]
    v_pk_add_f32 v[26:27], v[26:27], s[30:31] op_sel:[0,1] op_sel_hi:[1,1] neg_lo:[1,0] neg_hi:[1,0]
    v_mfma_f32_16x16x32_bf16 v[44:47], v[144:147], v[200:203], v[44:47]
    v_cvt_pk_bf16_f32 v16, v16, v17
    v_cvt_pk_bf16_f32 v17, v18, v19
    v_mfma_f32_16x16x32_bf16 v[44:47], v[152:155], v[160:163], v[44:47]
    v_rcp_f32 v28, v28
    v_mfma_f32_16x16x32_bf16 v[44:47], v[192:195], v[156:159], v[44:47]
    v_rcp_f32 v29, v29
    v_mfma_f32_16x16x32_bf16 v[44:47], v[236:239], v[112:115], v[44:47]
    v_rcp_f32 v30, v30
    v_mfma_f32_16x16x32_bf16 v[44:47], v[232:235], v[168:171], v[44:47]
    v_rcp_f32 v31, v31
    v_mfma_f32_16x16x32_bf16 v[44:47], v[224:227], v[132:135], v[44:47]
    v_exp_f32 v32, v32
    v_mfma_f32_16x16x32_bf16 v[40:43], v[184:187], v[132:135], v[40:43]
    v_exp_f32 v33, v33
    v_mfma_f32_16x16x32_bf16 v[40:43], v[172:175], v[168:171], v[40:43]
    v_exp_f32 v34, v34
    v_mfma_f32_16x16x32_bf16 v[40:43], v[240:243], v[112:115], v[40:43]
    ds_write_b64 v15, v[16:17] offset:0
    v_exp_f32 v35, v35
    v_pk_mul_f32 v[36:37], v[36:37], s[28:29] op_sel:[0,1] op_sel_hi:[1,1]
    v_pk_mul_f32 v[38:39], v[38:39], s[28:29] op_sel:[0,1] op_sel_hi:[1,1]
    v_pk_mul_f32 v[44:45], v[44:45], s[28:29] op_sel:[0,1] op_sel_hi:[1,1]
    v_pk_mul_f32 v[46:47], v[46:47], s[28:29] op_sel:[0,1] op_sel_hi:[1,1]
    v_pk_mul_f32 v[24:25], v[24:25], v[28:29]
    v_pk_mul_f32 v[26:27], v[26:27], v[30:31]
    v_pk_fma_f32 v[32:33], v[32:33], s[30:31], s[30:31] op_sel_hi:[1,0,0] clamp
    v_pk_fma_f32 v[34:35], v[34:35], s[30:31], s[30:31] op_sel_hi:[1,0,0] clamp
    v_mfma_f32_16x16x32_bf16 v[40:43], v[128:131], v[156:159], v[40:43]
    v_cvt_pk_bf16_f32 v24, v24, v25
    v_cvt_pk_bf16_f32 v25, v26, v27
    v_mfma_f32_16x16x32_bf16 v[40:43], v[176:179], v[160:163], v[40:43]
    v_exp_f32 v36, v36
    v_mfma_f32_16x16x32_bf16 v[40:43], v[148:151], v[200:203], v[40:43]
    v_exp_f32 v37, v37
    v_mfma_f32_16x16x32_bf16 v[48:51], v[148:151], v[160:163], v[48:51]
    v_exp_f32 v38, v38
    v_mfma_f32_16x16x32_bf16 v[48:51], v[176:179], v[156:159], v[48:51]
    v_exp_f32 v39, v39
    v_mfma_f32_16x16x32_bf16 v[48:51], v[128:131], v[136:139], v[48:51]
    v_exp_f32 v44, v44
    v_mfma_f32_16x16x32_bf16 v[48:51], v[240:243], v[168:171], v[48:51]
    v_exp_f32 v45, v45
    v_mfma_f32_16x16x32_bf16 v[48:51], v[172:175], v[132:135], v[48:51]
    v_exp_f32 v46, v46
    v_mfma_f32_16x16x32_bf16 v[48:51], v[184:187], v[140:143], v[48:51]
    ds_write_b64 v15, v[24:25] offset:2304
    v_exp_f32 v47, v47
    v_pk_mul_f32 v[40:41], v[40:41], s[28:29] op_sel_hi:[1,0]
    v_pk_mul_f32 v[42:43], v[42:43], s[28:29] op_sel_hi:[1,0]
    v_pk_fma_f32 v[36:37], v[32:33], v[36:37], v[32:33]
    v_pk_fma_f32 v[38:39], v[34:35], v[38:39], v[34:35]
    v_pk_add_f32 v[32:33], v[32:33], s[30:31] op_sel:[0,1] op_sel_hi:[1,1] neg_lo:[1,0] neg_hi:[1,0]
    v_pk_add_f32 v[34:35], v[34:35], s[30:31] op_sel:[0,1] op_sel_hi:[1,1] neg_lo:[1,0] neg_hi:[1,0]
    v_mfma_f32_16x16x32_bf16 v[52:55], v[224:227], v[140:143], v[52:55]
    v_rcp_f32 v36, v36
    v_mfma_f32_16x16x32_bf16 v[52:55], v[232:235], v[132:135], v[52:55]
    v_rcp_f32 v37, v37
    v_mfma_f32_16x16x32_bf16 v[52:55], v[236:239], v[168:171], v[52:55]
    s_waitcnt lgkmcnt(0)
    v_rcp_f32 v38, v38
    v_mfma_f32_16x16x32_bf16 v[52:55], v[192:195], v[136:139], v[52:55]
    s_barrier
    v_rcp_f32 v39, v39
    v_mfma_f32_16x16x32_bf16 v[52:55], v[152:155], v[156:159], v[52:55]
    v_exp_f32 v40, v40
    v_mfma_f32_16x16x32_bf16 v[52:55], v[144:147], v[160:163], v[52:55]
    v_exp_f32 v41, v41
    v_exp_f32 v42, v42
    v_exp_f32 v43, v43
    v_pk_mul_f32 v[48:49], v[48:49], s[28:29] op_sel_hi:[1,0]
    v_pk_mul_f32 v[50:51], v[50:51], s[28:29] op_sel_hi:[1,0]
    v_pk_mul_f32 v[32:33], v[32:33], v[36:37]
    v_pk_mul_f32 v[34:35], v[34:35], v[38:39]
    v_pk_fma_f32 v[40:41], v[40:41], s[30:31], s[30:31] op_sel_hi:[1,0,0] clamp
    v_pk_fma_f32 v[42:43], v[42:43], s[30:31], s[30:31] op_sel_hi:[1,0,0] clamp
    v_pk_fma_f32 v[44:45], v[40:41], v[44:45], v[40:41]
    v_pk_fma_f32 v[46:47], v[42:43], v[46:47], v[42:43]
    v_pk_add_f32 v[40:41], v[40:41], s[30:31] op_sel:[0,1] op_sel_hi:[1,1] neg_lo:[1,0] neg_hi:[1,0]
    v_pk_add_f32 v[42:43], v[42:43], s[30:31] op_sel:[0,1] op_sel_hi:[1,1] neg_lo:[1,0] neg_hi:[1,0]
    v_mfma_f32_16x16x32_bf16 v[60:63], v[144:147], v[156:159], v[60:63]
    v_cvt_pk_bf16_f32 v32, v32, v33
    v_cvt_pk_bf16_f32 v33, v34, v35
    v_mfma_f32_16x16x32_bf16 v[60:63], v[152:155], v[136:139], v[60:63]
    v_rcp_f32 v44, v44
    v_mfma_f32_16x16x32_bf16 v[60:63], v[192:195], v[80:83], v[60:63]
    v_rcp_f32 v45, v45
    v_mfma_f32_16x16x32_bf16 v[60:63], v[236:239], v[132:135], v[60:63]
    v_rcp_f32 v46, v46
    v_mfma_f32_16x16x32_bf16 v[60:63], v[232:235], v[140:143], v[60:63]
    v_rcp_f32 v47, v47
    v_mfma_f32_16x16x32_bf16 v[60:63], v[224:227], v[180:183], v[60:63]
    v_exp_f32 v48, v48
    v_mfma_f32_16x16x32_bf16 v[56:59], v[184:187], v[180:183], v[56:59]
    v_exp_f32 v49, v49
    v_mfma_f32_16x16x32_bf16 v[56:59], v[172:175], v[140:143], v[56:59]
    v_exp_f32 v50, v50
    v_mfma_f32_16x16x32_bf16 v[56:59], v[240:243], v[132:135], v[56:59]
    ds_write_b64 v15, v[32:33] offset:4608
    v_exp_f32 v51, v51
    v_pk_mul_f32 v[52:53], v[52:53], s[28:29] op_sel:[0,1] op_sel_hi:[1,1]
    v_pk_mul_f32 v[54:55], v[54:55], s[28:29] op_sel:[0,1] op_sel_hi:[1,1]
    v_pk_mul_f32 v[60:61], v[60:61], s[28:29] op_sel:[0,1] op_sel_hi:[1,1]
    v_pk_mul_f32 v[62:63], v[62:63], s[28:29] op_sel:[0,1] op_sel_hi:[1,1]
    v_pk_mul_f32 v[40:41], v[40:41], v[44:45]
    v_pk_mul_f32 v[42:43], v[42:43], v[46:47]
    v_pk_fma_f32 v[48:49], v[48:49], s[30:31], s[30:31] op_sel_hi:[1,0,0] clamp
    v_pk_fma_f32 v[50:51], v[50:51], s[30:31], s[30:31] op_sel_hi:[1,0,0] clamp
    v_mfma_f32_16x16x32_bf16 v[56:59], v[128:131], v[80:83], v[56:59]
    v_cvt_pk_bf16_f32 v40, v40, v41
    v_cvt_pk_bf16_f32 v41, v42, v43
    v_mfma_f32_16x16x32_bf16 v[56:59], v[176:179], v[136:139], v[56:59]
    v_exp_f32 v52, v52
    v_mfma_f32_16x16x32_bf16 v[56:59], v[148:151], v[156:159], v[56:59]
    v_exp_f32 v53, v53
    v_mfma_f32_16x16x32_bf16 v[64:67], v[104:107], v[228:231], v[64:67]
    v_exp_f32 v54, v54
    v_mfma_f32_16x16x32_bf16 v[64:67], v[100:103], v[92:95], v[64:67]
    v_exp_f32 v55, v55
    v_mfma_f32_16x16x32_bf16 v[64:67], v[96:99], v[208:211], v[64:67]
    v_exp_f32 v60, v60
    v_mfma_f32_16x16x32_bf16 v[64:67], v[148:151], v[136:139], v[64:67]
    v_exp_f32 v61, v61
    v_mfma_f32_16x16x32_bf16 v[64:67], v[176:179], v[80:83], v[64:67]
    v_exp_f32 v62, v62
    v_mfma_f32_16x16x32_bf16 v[64:67], v[128:131], v[216:219], v[64:67]
    ds_write_b64 v15, v[40:41] offset:6912
    v_exp_f32 v63, v63
    v_pk_mul_f32 v[56:57], v[56:57], s[28:29] op_sel_hi:[1,0]
    v_pk_mul_f32 v[58:59], v[58:59], s[28:29] op_sel_hi:[1,0]
    v_pk_fma_f32 v[52:53], v[48:49], v[52:53], v[48:49]
    v_pk_fma_f32 v[54:55], v[50:51], v[54:55], v[50:51]
    v_pk_add_f32 v[48:49], v[48:49], s[30:31] op_sel:[0,1] op_sel_hi:[1,1] neg_lo:[1,0] neg_hi:[1,0]
    v_pk_add_f32 v[50:51], v[50:51], s[30:31] op_sel:[0,1] op_sel_hi:[1,1] neg_lo:[1,0] neg_hi:[1,0]
    v_mfma_f32_16x16x32_bf16 v[64:67], v[240:243], v[140:143], v[64:67]
    v_rcp_f32 v52, v52
    v_mfma_f32_16x16x32_bf16 v[64:67], v[172:175], v[180:183], v[64:67]
    v_rcp_f32 v53, v53
    v_mfma_f32_16x16x32_bf16 v[64:67], v[184:187], v[220:223], v[64:67]
    s_waitcnt lgkmcnt(0)
    v_rcp_f32 v54, v54
    v_mfma_f32_16x16x32_bf16 v[68:71], v[224:227], v[220:223], v[68:71]
    s_barrier
    v_rcp_f32 v55, v55
    v_mfma_f32_16x16x32_bf16 v[68:71], v[232:235], v[180:183], v[68:71]
    v_exp_f32 v56, v56
    v_mfma_f32_16x16x32_bf16 v[68:71], v[236:239], v[140:143], v[68:71]
    v_exp_f32 v57, v57
    v_exp_f32 v58, v58
    v_exp_f32 v59, v59
    v_pk_mul_f32 v[64:65], v[64:65], s[28:29] op_sel_hi:[1,0]
    v_pk_mul_f32 v[66:67], v[66:67], s[28:29] op_sel_hi:[1,0]
    v_pk_mul_f32 v[48:49], v[48:49], v[52:53]
    v_pk_mul_f32 v[50:51], v[50:51], v[54:55]
    v_pk_fma_f32 v[56:57], v[56:57], s[30:31], s[30:31] op_sel_hi:[1,0,0] clamp
    v_pk_fma_f32 v[58:59], v[58:59], s[30:31], s[30:31] op_sel_hi:[1,0,0] clamp
    v_pk_fma_f32 v[60:61], v[56:57], v[60:61], v[56:57]
    v_pk_fma_f32 v[62:63], v[58:59], v[62:63], v[58:59]
    v_pk_add_f32 v[56:57], v[56:57], s[30:31] op_sel:[0,1] op_sel_hi:[1,1] neg_lo:[1,0] neg_hi:[1,0]
    v_pk_add_f32 v[58:59], v[58:59], s[30:31] op_sel:[0,1] op_sel_hi:[1,1] neg_lo:[1,0] neg_hi:[1,0]
    v_mfma_f32_16x16x32_bf16 v[68:71], v[192:195], v[216:219], v[68:71]
    v_cvt_pk_bf16_f32 v48, v48, v49
    v_cvt_pk_bf16_f32 v49, v50, v51
    v_mfma_f32_16x16x32_bf16 v[68:71], v[152:155], v[80:83], v[68:71]
    v_rcp_f32 v60, v60
    v_mfma_f32_16x16x32_bf16 v[68:71], v[144:147], v[136:139], v[68:71]
    v_rcp_f32 v61, v61
    v_mfma_f32_16x16x32_bf16 v[68:71], v[164:167], v[208:211], v[68:71]
    v_rcp_f32 v62, v62
    v_mfma_f32_16x16x32_bf16 v[68:71], v[124:127], v[92:95], v[68:71]
    v_rcp_f32 v63, v63
    v_mfma_f32_16x16x32_bf16 v[68:71], v[212:215], v[228:231], v[68:71]
    v_exp_f32 v64, v64
    v_mfma_f32_16x16x32_bf16 v[76:79], v[212:215], v[92:95], v[76:79]
    v_exp_f32 v65, v65
    v_mfma_f32_16x16x32_bf16 v[76:79], v[124:127], v[208:211], v[76:79]
    v_exp_f32 v66, v66
    v_mfma_f32_16x16x32_bf16 v[76:79], v[164:167], v[244:247], v[76:79]
    ds_write_b64 v15, v[48:49] offset:9216
    v_exp_f32 v67, v67
    v_pk_mul_f32 v[68:69], v[68:69], s[28:29] op_sel:[0,1] op_sel_hi:[1,1]
    v_pk_mul_f32 v[70:71], v[70:71], s[28:29] op_sel:[0,1] op_sel_hi:[1,1]
    v_pk_mul_f32 v[56:57], v[56:57], v[60:61]
    v_pk_mul_f32 v[58:59], v[58:59], v[62:63]
    v_pk_fma_f32 v[64:65], v[64:65], s[30:31], s[30:31] op_sel_hi:[1,0,0] clamp
    v_pk_fma_f32 v[66:67], v[66:67], s[30:31], s[30:31] op_sel_hi:[1,0,0] clamp
    v_mfma_f32_16x16x32_bf16 v[76:79], v[144:147], v[80:83], v[76:79]
    v_cvt_pk_bf16_f32 v56, v56, v57
    v_cvt_pk_bf16_f32 v57, v58, v59
    v_mfma_f32_16x16x32_bf16 v[76:79], v[152:155], v[216:219], v[76:79]
    ds_write_b64 v15, v[56:57] offset:11520
    v_mfma_f32_16x16x32_bf16 v[76:79], v[192:195], v[84:87], v[76:79]
    v_exp_f32 v68, v68
    v_mfma_f32_16x16x32_bf16 v[76:79], v[236:239], v[180:183], v[76:79]
    v_exp_f32 v69, v69
    v_mfma_f32_16x16x32_bf16 v[76:79], v[232:235], v[220:223], v[76:79]
    s_waitcnt lgkmcnt(0)
    v_exp_f32 v70, v70
    v_mfma_f32_16x16x32_bf16 v[76:79], v[224:227], v[88:91], v[76:79]
    s_barrier
    v_exp_f32 v71, v71
    v_mfma_f32_16x16x32_bf16 v[72:75], v[184:187], v[88:91], v[72:75]
    v_fma_f32 v68, v64, v68, v64
    v_fma_f32 v69, v65, v69, v65
    v_mfma_f32_16x16x32_bf16 v[72:75], v[172:175], v[220:223], v[72:75]
    v_fma_f32 v70, v66, v70, v66
    v_fma_f32 v71, v67, v71, v67
    v_mfma_f32_16x16x32_bf16 v[72:75], v[240:243], v[180:183], v[72:75]
    v_rcp_f32 v68, v68
    v_rcp_f32 v69, v69
    v_rcp_f32_e64 v70, v70
    v_pk_mul_f32 v[76:77], v[76:77], s[28:29] op_sel:[0,1] op_sel_hi:[1,1]
    v_pk_mul_f32 v[78:79], v[78:79], s[28:29] op_sel:[0,1] op_sel_hi:[1,1]
    v_pk_add_f32 v[64:65], v[64:65], s[30:31] op_sel:[0,1] op_sel_hi:[1,1] neg_lo:[1,0] neg_hi:[1,0]
    v_pk_add_f32 v[66:67], v[66:67], s[30:31] op_sel:[0,1] op_sel_hi:[1,1] neg_lo:[1,0] neg_hi:[1,0]
    v_mfma_f32_16x16x32_bf16 v[72:75], v[128:131], v[84:87], v[72:75]
    v_rcp_f32 v71, v71
    v_mfma_f32_16x16x32_bf16 v[72:75], v[176:179], v[216:219], v[72:75]
    v_exp_f32 v76, v76
    v_mfma_f32_16x16x32_bf16 v[72:75], v[148:151], v[80:83], v[72:75]
    v_exp_f32 v77, v77
    v_mfma_f32_16x16x32_bf16 v[72:75], v[96:99], v[244:247], v[72:75]
    v_exp_f32 v78, v78
    v_mfma_f32_16x16x32_bf16 v[72:75], v[100:103], v[208:211], v[72:75]
    v_exp_f32 v79, v79
    v_mfma_f32_16x16x32_bf16 v[72:75], v[104:107], v[92:95], v[72:75]
    v_mul_f32 v64, v64, v68
    v_mul_f32 v65, v65, v69
    v_mul_f32 v66, v66, v70
    v_mul_f32 v67, v67, v71
    v_cvt_pk_bf16_f32 v64, v64, v65
    v_cvt_pk_bf16_f32 v65, v66, v67
    ds_write_b64 v15, v[64:65] offset:13824
    s_nop 0
    v_pk_mul_f32 v[72:73], v[72:73], s[28:29] op_sel_hi:[1,0]
    v_pk_mul_f32 v[74:75], v[74:75], s[28:29] op_sel_hi:[1,0]
    v_exp_f32 v72, v72
    v_exp_f32 v73, v73
    v_exp_f32 v74, v74
    v_exp_f32 v75, v75
    v_pk_fma_f32 v[72:73], v[72:73], s[30:31], s[30:31] op_sel_hi:[1,0,0] clamp
    v_pk_fma_f32 v[74:75], v[74:75], s[30:31], s[30:31] op_sel_hi:[1,0,0] clamp
    v_pk_fma_f32 v[76:77], v[72:73], v[76:77], v[72:73]
    v_pk_fma_f32 v[78:79], v[74:75], v[78:79], v[74:75]
    v_rcp_f32 v76, v76
    v_rcp_f32 v77, v77
    v_rcp_f32 v78, v78
    v_rcp_f32 v79, v79
    v_pk_add_f32 v[72:73], v[72:73], s[30:31] op_sel:[0,1] op_sel_hi:[1,1] neg_lo:[1,0] neg_hi:[1,0]
    v_pk_add_f32 v[74:75], v[74:75], s[30:31] op_sel:[0,1] op_sel_hi:[1,1] neg_lo:[1,0] neg_hi:[1,0]
    v_pk_mul_f32 v[72:73], v[72:73], v[76:77]
    v_pk_mul_f32 v[74:75], v[74:75], v[78:79]
    v_cvt_pk_bf16_f32 v72, v72, v73
    v_cvt_pk_bf16_f32 v73, v74, v75
    ds_write_b64 v15, v[72:73] offset:16128
    s_waitcnt lgkmcnt(0)
    s_barrier
L_end:
    s_endpgm
.section .rodata,"a"
.p2align 6
.amdhsa_kernel standalone__autoregressive_conv_wavernn__speech_kernel
  .amdhsa_next_free_vgpr 248
  .amdhsa_next_free_sgpr 32
  .amdhsa_accum_offset 248
  .amdhsa_group_segment_fixed_size 0
  .amdhsa_kernarg_size 40
  .amdhsa_user_sgpr_count 2
  .amdhsa_user_sgpr_kernarg_segment_ptr 1
  .amdhsa_system_sgpr_workgroup_id_x 1
.end_amdhsa_kernel
```
